```python
import torch

def _softmax(x, axis=-1):
    return torch.softmax(x, dim=axis)
def _gelu(x):
    return torch.nn.functional.gelu(x, approximate="tanh")
def _silu(x):
    return torch.nn.functional.silu(x)
def _sigmoid(x):
    return torch.sigmoid(x)
def _layernorm(x, axis=-1, eps=1e-5):
    m = x.mean(dim=axis, keepdim=True)
    v = x.var(dim=axis, keepdim=True, unbiased=False)
    return (x - m) / torch.sqrt(v + eps)
def _scatter_add(tgt, idx, src, axis=0):
    return tgt.clone().index_add_(axis, idx, src)
def _segment_sum(src, seg, n):
    out = torch.zeros((n,) + src.shape[1:], dtype=src.dtype)
    return out.index_add_(0, seg, src)
def _pad(x, pw):
    flat = tuple(v for pair in reversed(pw) for v in pair)
    return torch.nn.functional.pad(x, flat)

kernel_name = 'parallel_sum__gqa_block_cached__glu_gated_geglu__decode'

def setup_inputs():

    _w = (lambda a: (lambda t: t.to(torch.bfloat16) if t.is_floating_point() else t)(torch.as_tensor(a)))
    def _A_setup():
        B, Sq, D = 1, 1, 640
        Hq, Hkv, Sk, Dh = 32, 32, 8192, 192
        assert Hq % Hkv == 0, (Hq, Hkv)
        return {
            "x": _w((lambda *s: torch.randn(*s, dtype=torch.bfloat16) * 0.05)(B, Sq, D)),
            "k_cache": _w((lambda *s: torch.randn(*s, dtype=torch.bfloat16) * 1.6)(B, Hkv, Sk, Dh)),
            "v_cache": _w((lambda *s: torch.randn(*s, dtype=torch.bfloat16) * 0.8)(B, Hkv, Sk, Dh)),
            "wq": _w((lambda *s: torch.randn(*s, dtype=torch.bfloat16) * 1.6)(D, Hq * Dh) * (D ** -0.5)),
            "wo": _w((lambda *s: torch.randn(*s, dtype=torch.bfloat16) * 0.8)(Hq * Dh, D) * ((Hq * Dh) ** -0.5)),
        }
    _A_in = _A_setup()

    def _B_setup():
        B, S, Dm, Df = 1, 1, 640, 1536
        return {
            "x": _w((lambda *s: torch.randn(*s, dtype=torch.bfloat16) * 0.05)(B, S, Dm)),
            "w_gate": _w((lambda *s: torch.randn(*s, dtype=torch.bfloat16) * 0.4)(Dm, Df) * (Dm ** -0.5)),
            "w_up": _w((lambda *s: torch.randn(*s, dtype=torch.bfloat16) * 0.4)(Dm, Df) * (Dm ** -0.5)),
            "w_down": _w((lambda *s: torch.randn(*s, dtype=torch.bfloat16) * 0.4)(Df, Dm) * (Df ** -0.5)),
        }
    _B_in = _B_setup()

    return {
        "A_x": _A_in["x"],
        "A_k_cache": _A_in["k_cache"],
        "A_v_cache": _A_in["v_cache"],
        "A_wq": _A_in["wq"],
        "A_wo": _A_in["wo"],
        "B_x": _B_in["x"],
        "B_w_gate": _B_in["w_gate"],
        "B_w_up": _B_in["w_up"],
        "B_w_down": _B_in["w_down"],
    }

def reference(A_x, A_k_cache, A_v_cache, A_wq, A_wo, B_x, B_w_gate, B_w_up, B_w_down):
    def _A_ref(x, k_cache, v_cache, wq, wo):
        B, Sq, D = x.shape
        Hq, Dh = 32, 192
        Hkv = k_cache.shape[1]
        rep = Hq // Hkv
        q = (lambda x, *d: x.permute(*d))((x @ wq).reshape(B, Sq, Hq, Dh), 0, 2, 1, 3)
        k = (lambda x, n, axis: torch.repeat_interleave(x, n, dim=axis))(k_cache, rep, axis=1)
        v = (lambda x, n, axis: torch.repeat_interleave(x, n, dim=axis))(v_cache, rep, axis=1)
        scores = torch.einsum("bhqd,bhkd->bhqk", q, k) * (Dh ** -0.5)
        p = _softmax(scores, axis=-1)
        o = torch.einsum("bhqk,bhkd->bhqd", p, v)
        return (lambda x, *d: x.permute(*d))(o, 0, 2, 1, 3).reshape(B, Sq, Hq * Dh) @ wo

    def _B_ref(x, w_gate, w_up, w_down):
        g = torch.einsum("bsd,df->bsf", x, w_gate)
        u = torch.einsum("bsd,df->bsf", x, w_up)
        h = _gelu(g) * u
        return torch.einsum("bsf,fd->bsd", h, w_down)

    x = A_x
    xn = _layernorm(x, axis=-1)
    return x + _A_ref(xn, A_k_cache, A_v_cache, A_wq, A_wo) + _B_ref(xn, B_w_gate, B_w_up, B_w_down)
```

```asm
; @launch grid=(256,1,1) block=(576,1,1) lds=33792
.amdgcn_target "amdgcn-amd-amdhsa--gfx950"
.text
.globl parallel_sum__gqa_block_cached__glu_gated_geglu__decode_kernel
.p2align 8
.type parallel_sum__gqa_block_cached__glu_gated_geglu__decode_kernel,@function
parallel_sum__gqa_block_cached__glu_gated_geglu__decode_kernel:
    s_cmp_ge_u32 s2, 256
    s_cbranch_scc1 L_end
    s_load_dwordx16 s[16:31], s[0:1], 0
    s_load_dwordx8 s[32:39], s[0:1], 64
    v_lshrrev_b32 v4, 6, v0
    v_and_b32 v1, 63, v0
    s_and_b32 s4, s2, 31
    s_lshr_b32 s5, s2, 5
    v_readfirstlane_b32 s6, v4
    v_lshrrev_b32 v4, 3, v1
    v_and_b32 v15, 7, v1
    v_lshlrev_b32 v5, 4, v15
    v_lshlrev_b32 v6, 2, v1
    v_lshlrev_b32 v0, 4, v1
    s_lshl_b32 s3, s4, 3
    s_add_u32 s3, s3, s5
    s_and_b32 s63, s4, 7
    s_lshl_b32 s63, s63, 2
    s_lshr_b32 s7, s4, 3
    s_add_u32 s63, s63, s7
    s_cmp_lg_u32 s6, 8
    s_cbranch_scc1 L_str
    s_setprio 3
    s_mov_b32 s46, 1280
    s_mov_b32 s47, 0x20000
    s_waitcnt lgkmcnt(0)
    s_mov_b32 s44, s16
    s_mov_b32 s45, s17
    buffer_load_dword v10, v6, s[44:47], 0 offen offset:0
    buffer_load_dword v11, v6, s[44:47], 0 offen offset:256
    buffer_load_dword v12, v6, s[44:47], 0 offen offset:512
    buffer_load_dword v13, v6, s[44:47], 0 offen offset:768
    buffer_load_dword v14, v6, s[44:47], 0 offen offset:1024
    s_barrier
    s_branch L_ctl
L_str:
    s_mul_i32 s8, s5, 80
    s_lshl_b32 s7, s6, 3
    s_add_u32 s8, s8, s7
    s_mul_i32 s14, s8, 12288
    s_mul_i32 s13, s4, 384
    s_add_u32 s14, s14, s13
    s_mul_i32 s60, s8, 3072
    s_mul_i32 s13, s63, 96
    s_add_u32 s60, s60, s13
    s_add_u32 s15, s14, 786432
    s_add_u32 s61, s60, 196608
    s_cmp_lt_u32 s6, 2
    s_cselect_b32 s9, 64, 0
    v_mul_u32_u24 v7, 12288, v4
    v_add_u32 v7, v7, v5
    v_mul_u32_u24 v10, 3072, v4
    v_add_u32 v10, v10, v5
    v_cmp_lt_u32 vcc, 5, v15
    v_mov_b32 v9, 0x7ff00000
    v_mul_u32_u24 v2, 384, v4
    v_add_u32 v2, v2, v5
    v_cndmask_b32 v10, v10, v9, vcc
    s_mul_i32 s11, s6, 3
    s_add_u32 s11, s11, s5
    s_and_b32 s11, s11, 7
    s_add_u32 s11, s11, s7
    s_mul_i32 s10, s4, 3145728
    s_mul_i32 s11, s11, 3072
    s_add_u32 s10, s10, s11
    s_mov_b32 s12, s10
    s_mov_b32 s42, 100663296
    s_mov_b32 s43, 0x20000
    s_mov_b32 s46, 7864320
    s_mov_b32 s47, 0x20000
    s_mov_b32 s50, 1966080
    s_mov_b32 s51, 0x20000
    s_mov_b32 s54, 1966080
    s_mov_b32 s55, 0x20000
    s_waitcnt lgkmcnt(0)
    s_mov_b32 s44, s22
    s_mov_b32 s45, s23
    buffer_load_dwordx4 v[88:91], v7, s[44:47], s14 offen offset:0 nt
    buffer_load_dwordx4 v[92:95], v7, s[44:47], s14 offen offset:128 nt
    buffer_load_dwordx4 v[96:99], v7, s[44:47], s14 offen offset:256 nt
    s_mov_b32 s48, s28
    s_mov_b32 s49, s29
    s_mov_b32 s52, s30
    s_mov_b32 s53, s31
    buffer_load_dwordx4 v[112:115], v10, s[48:51], s60 offen nt
    buffer_load_dwordx4 v[116:119], v10, s[52:55], s60 offen nt
    s_cmp_ge_u32 s6, 2
    s_cbranch_scc1 L_g1
    buffer_load_dwordx4 v[100:103], v7, s[44:47], s15 offen offset:0 nt
    buffer_load_dwordx4 v[104:107], v7, s[44:47], s15 offen offset:128 nt
    buffer_load_dwordx4 v[108:111], v7, s[44:47], s15 offen offset:256 nt
    buffer_load_dwordx4 v[120:123], v10, s[48:51], s61 offen nt
    buffer_load_dwordx4 v[124:127], v10, s[52:55], s61 offen nt
L_g1:
    s_mov_b32 s40, s18
    s_mov_b32 s41, s19
    s_barrier
    buffer_load_dwordx4 v[64:67], v2, s[40:43], s12 offen offset:0 nt
    buffer_load_dwordx4 v[68:71], v2, s[40:43], s12 offen offset:128 nt
    buffer_load_dwordx4 v[72:75], v2, s[40:43], s12 offen offset:256 nt
    s_add_u32 s12, s12, 196608
    buffer_load_dwordx4 v[76:79], v2, s[40:43], s12 offen offset:0 nt
    buffer_load_dwordx4 v[80:83], v2, s[40:43], s12 offen offset:128 nt
    buffer_load_dwordx4 v[84:87], v2, s[40:43], s12 offen offset:256 nt
    s_add_u32 s12, s12, 196608
    s_mov_b32 s56, s38
    s_mov_b32 s57, s39
    s_mov_b32 s58, 2621440
    s_mov_b32 s59, 0x20000
    s_mov_b32 s64, s24
    s_mov_b32 s65, s25
    s_mov_b32 s66, 7864320
    s_mov_b32 s67, 0x20000
    s_mov_b32 s72, s34
    s_mov_b32 s73, s35
    s_mov_b32 s74, 1280
    s_mov_b32 s75, 0x20000
    s_add_u32 s60, s38, 950272
    s_addc_u32 s61, s39, 0
    s_load_dword s62, s[60:61], 0
    v_mov_b32 v40, 0
    v_mov_b32 v41, 0
    v_mov_b32 v42, 0
    v_mov_b32 v43, 0
    v_mov_b32 v44, 0
    v_mov_b32 v45, 0
    v_mov_b32 v46, 0
    v_mov_b32 v47, 0
    v_mov_b32 v48, 0
    v_mov_b32 v49, 0
    v_mov_b32 v50, 0
    v_mov_b32 v51, 0
    v_mov_b32 v52, 0
    v_mov_b32 v53, 0
    v_mov_b32 v54, 0
    v_mov_b32 v55, 0
    v_mov_b32 v56, 0
    v_mov_b32 v57, 0
    v_mov_b32 v58, 0
    v_mov_b32 v59, 0
    v_and_b32 v12, 1, v1
    v_lshlrev_b32 v12, 4, v12
    v_mov_b32 v13, 0xffff
    v_lshlrev_b32 v12, v12, v13
    v_lshrrev_b32 v13, 1, v15
    v_cmp_eq_u32 vcc, 0, v13
    s_nop 1
    v_cndmask_b32 v140, 0, v12, vcc
    v_cmp_eq_u32 vcc, 1, v13
    s_nop 1
    v_cndmask_b32 v141, 0, v12, vcc
    v_cmp_eq_u32 vcc, 2, v13
    s_nop 1
    v_cndmask_b32 v142, 0, v12, vcc
    v_cmp_eq_u32 vcc, 3, v13
    s_nop 1
    v_cndmask_b32 v143, 0, v12, vcc
    v_add_u32 v8, s8, v4
    v_add_u32 v7, s9, v8
    v_lshlrev_b32 v8, 1, v8
    v_lshlrev_b32 v7, 1, v7
    v_cmp_lt_u32 vcc, 39, v1
    s_lshl_b32 s11, s6, 10
    v_add_u32 v18, s11, v0
    v_lshrrev_b32 v19, 1, v18
    v_cndmask_b32 v3, v6, v9, vcc
    s_barrier
    ds_read_u16 v10, v8 offset:12288
    ds_read_u16 v12, v7 offset:12288
    s_waitcnt lgkmcnt(0)
    v_lshl_or_b32 v10, v10, 16, v10
    v_lshl_or_b32 v12, v12, 16, v12
    v_and_b32 v24, v10, v140
    v_and_b32 v25, v10, v141
    v_and_b32 v26, v10, v142
    v_and_b32 v27, v10, v143
    v_and_b32 v28, v12, v140
    v_and_b32 v29, v12, v141
    v_and_b32 v30, v12, v142
    v_and_b32 v31, v12, v143
    s_cmp_ge_u32 s6, 2
    s_waitcnt vmcnt(6)
    s_cbranch_scc1 L_g2
    v_mfma_f32_16x16x32_bf16 v[40:43], v[28:31], v[100:103], v[40:43]
    v_mfma_f32_16x16x32_bf16 v[44:47], v[28:31], v[104:107], v[44:47]
    v_mfma_f32_16x16x32_bf16 v[48:51], v[28:31], v[108:111], v[48:51]
    v_mfma_f32_16x16x32_bf16 v[52:55], v[28:31], v[120:123], v[52:55]
    v_mfma_f32_16x16x32_bf16 v[56:59], v[28:31], v[124:127], v[56:59]
L_g2:
    v_mfma_f32_16x16x32_bf16 v[40:43], v[24:27], v[88:91], v[40:43]
    v_mfma_f32_16x16x32_bf16 v[44:47], v[24:27], v[92:95], v[44:47]
    v_mfma_f32_16x16x32_bf16 v[48:51], v[24:27], v[96:99], v[48:51]
    v_mfma_f32_16x16x32_bf16 v[52:55], v[24:27], v[112:115], v[52:55]
    v_mfma_f32_16x16x32_bf16 v[56:59], v[24:27], v[116:119], v[56:59]
    s_nop 3
    v_permlane32_swap_b32 v40, v42
    v_permlane32_swap_b32 v41, v43
    v_permlane32_swap_b32 v44, v46
    v_permlane32_swap_b32 v45, v47
    v_permlane32_swap_b32 v48, v50
    v_permlane32_swap_b32 v49, v51
    v_permlane32_swap_b32 v52, v54
    v_permlane32_swap_b32 v53, v55
    v_permlane32_swap_b32 v56, v58
    v_permlane32_swap_b32 v57, v59
    v_add_f32_dpp v20, v42, v40 row_ror:8 row_mask:0xf bank_mask:0x3
    v_add_f32_dpp v21, v46, v44 row_ror:8 row_mask:0xf bank_mask:0x3
    v_add_f32_dpp v22, v50, v48 row_ror:8 row_mask:0xf bank_mask:0x3
    v_add_f32_dpp v16, v54, v52 row_ror:8 row_mask:0xf bank_mask:0x3
    v_add_f32_dpp v17, v58, v56 row_ror:8 row_mask:0xf bank_mask:0x3
    v_add_f32_dpp v20, v41, v43 row_ror:8 row_mask:0xf bank_mask:0xc
    v_add_f32_dpp v21, v45, v47 row_ror:8 row_mask:0xf bank_mask:0xc
    v_add_f32_dpp v22, v49, v51 row_ror:8 row_mask:0xf bank_mask:0xc
    v_add_f32_dpp v16, v53, v55 row_ror:8 row_mask:0xf bank_mask:0xc
    v_add_f32_dpp v17, v57, v59 row_ror:8 row_mask:0xf bank_mask:0xc
    ds_write_b128 v18, v[20:23] offset:0
    ds_write_b64 v19, v[16:17] offset:8192
    s_waitcnt lgkmcnt(0)
    s_barrier
    s_waitcnt vmcnt(0)
    s_mul_i32 s11, s4, 192
    s_mul_i32 s13, s6, 24
    s_add_u32 s11, s11, s13
    s_mul_i32 s11, s11, 1280
    s_mul_i32 s9, s5, 160
    s_add_u32 s54, s11, s9
    s_mov_b32 s52, 0x05040100
    s_mov_b32 s53, 0x07060302
    s_mov_b32 s44, s20
    s_mov_b32 s45, s21
    s_mov_b32 s46, 100663296
    s_mov_b32 s47, 0x20000
    buffer_load_dwordx4 v[144:147], v2, s[44:47], s10 offen offset:0 nt
    buffer_load_dwordx4 v[148:151], v2, s[44:47], s10 offen offset:128 nt
    buffer_load_dwordx4 v[152:155], v2, s[44:47], s10 offen offset:256 nt
    v_mov_b32 v27, v3
    s_add_u32 s11, s54, 0
    buffer_load_dword v114, v3, s[64:67], s11 offen offset:0 nt
    buffer_load_dword v115, v3, s[64:67], s11 offen offset:1280 nt
    buffer_load_dword v118, v3, s[64:67], s11 offen offset:2560 nt
    s_add_u32 s11, s54, 3840
    buffer_load_dword v116, v3, s[64:67], s11 offen offset:0 nt
    buffer_load_dword v117, v3, s[64:67], s11 offen offset:1280 nt
    buffer_load_dword v119, v3, s[64:67], s11 offen offset:2560 nt
    s_add_u32 s11, s54, 7680
    buffer_load_dword v120, v3, s[64:67], s11 offen offset:0 nt
    buffer_load_dword v121, v3, s[64:67], s11 offen offset:1280 nt
    s_add_u32 s11, s54, 11520
    buffer_load_dword v122, v3, s[64:67], s11 offen offset:0 nt
    buffer_load_dword v123, v3, s[64:67], s11 offen offset:1280 nt
    v_mov_b32 v16, 0
    v_mov_b32 v17, 0
    v_mov_b32 v18, 0
    v_mov_b32 v19, 0
    s_add_u32 s62, s62, 0x9e3779b1
    s_lshl_b32 s7, s4, 14
    s_lshl_b32 s8, s6, 7
    s_add_u32 s7, s7, s8
    s_add_u32 s7, s7, 2097152
    s_lshl_b32 s8, s6, 10
    v_lshl_add_u32 v0, v4, 11, v5
    s_add_u32 s55, s62, 16
    v_bfe_u32 v4, v1, 3, 1
    v_bfe_u32 v9, v1, 4, 1
    v_lshl_add_u32 v4, v9, 2, v4
    v_lshrrev_b32 v9, 5, v1
    v_lshl_add_u32 v4, v9, 1, v4
    v_lshl_add_u32 v9, v15, 3, v4
    v_add_u32 v9, 0, v9
    v_mul_u32_u24 v10, 171, v9
    v_lshrrev_b32 v10, 9, v10
    v_add_lshl_u32 v20, v9, v10, 2
    v_add_u32 v20, s8, v20
    v_lshl_add_u32 v9, v15, 3, v4
    v_add_u32 v9, 64, v9
    v_mul_u32_u24 v10, 171, v9
    v_lshrrev_b32 v10, 9, v10
    v_add_lshl_u32 v21, v9, v10, 2
    v_add_u32 v21, s8, v21
    v_lshl_add_u32 v9, v15, 3, v4
    v_add_u32 v9, 128, v9
    v_mul_u32_u24 v10, 171, v9
    v_lshrrev_b32 v10, 9, v10
    v_add_lshl_u32 v22, v9, v10, 2
    v_add_u32 v22, s8, v22
    s_xor_b32 s63, s4, 0
    s_mov_b32 s13, s6
    s_cmp_lt_u32 s13, 7
    s_cselect_b32 s63, s63, 1
    s_lshl_b32 s14, s13, 6
    s_lshl_b32 s15, s5, 9
    s_add_u32 s14, s14, s15
    s_add_u32 s14, s14, 786432
    s_add_u32 s15, s14, 65536
    s_mul_i32 s13, s13, 12
    v_and_b32 v9, 3, v1
    v_lshrrev_b32 v7, 2, v1
    v_lshlrev_b32 v7, 12, v7
    v_lshl_add_u32 v7, v9, 4, v7
    v_mul_u32_u24 v9, 3, v9
    v_lshrrev_b32 v10, 4, v1
    v_add3_u32 v9, v9, v10, s13
    v_lshlrev_b32 v23, 1, v9
    v_cmp_gt_u32 vcc, 80, v9
    s_mov_b32 s48, 0x000f000f
    s_mov_b32 s49, 0x0000000f
    s_and_b64 s[48:49], s[48:49], vcc
    v_add_u32 v9, s9, v23
    ds_read_u16 v8, v9 offset:13568
    v_lshlrev_b32 v9, 1, v1
    v_mul_u32_u24 v10, 171, v9
    v_lshrrev_b32 v10, 9, v10
    v_add_lshl_u32 v3, v9, v10, 2
    v_add_u32 v9, 1, v9
    v_mul_u32_u24 v10, 171, v9
    v_lshrrev_b32 v10, 9, v10
    v_add_lshl_u32 v4, v9, v10, 2
    v_add_u32 v3, s8, v3
    v_add_u32 v4, s8, v4
    s_waitcnt vmcnt(0) lgkmcnt(0)
    buffer_load_dwordx4 v[88:91], v2, s[40:43], s12 offen offset:0 nt
    buffer_load_dwordx4 v[92:95], v2, s[40:43], s12 offen offset:128 nt
    buffer_load_dwordx4 v[96:99], v2, s[40:43], s12 offen offset:256 nt
    s_add_u32 s12, s12, 196608
    v_lshlrev_b32 v8, 16, v8
    s_mov_b32 s8, 0
    s_waitcnt vmcnt(3)
    v_perm_b32 v112, v115, v114, s52
    v_perm_b32 v113, v115, v114, s53
    v_perm_b32 v114, v117, v116, s52
    v_perm_b32 v115, v117, v116, s53
    v_perm_b32 v116, v119, v118, s52
    v_perm_b32 v117, v119, v118, s53
    v_perm_b32 v118, v121, v120, s52
    v_perm_b32 v119, v121, v120, s53
    v_perm_b32 v120, v123, v122, s52
    v_perm_b32 v121, v123, v122, s53
    s_waitcnt vmcnt(0)
    buffer_load_dwordx4 v[100:103], v2, s[40:43], s12 offen offset:0 nt
    buffer_load_dwordx4 v[104:107], v2, s[40:43], s12 offen offset:128 nt
    buffer_load_dwordx4 v[108:111], v2, s[40:43], s12 offen offset:256 nt
    s_add_u32 s12, s12, 196608
    v_mov_b32 v9, 0
    s_mov_b32 s13, 4800000
L_waitq:
    ds_read_b32 v14, v9 offset:15808
    s_sub_u32 s13, s13, 1
    s_cbranch_scc1 L_waitqx
    s_waitcnt lgkmcnt(0)
    v_cmp_eq_u32 vcc, -1, v14
    s_cbranch_vccz L_waitqx
    s_sleep 2
    s_branch L_waitq
L_waitqx:
    ds_read_b128 v[40:43], v5 offset:15360
    ds_read_b128 v[44:47], v5 offset:15488
    ds_read_b128 v[48:51], v5 offset:15616
    s_waitcnt lgkmcnt(0)
    s_branch L_k0
L_kloop:
    s_waitcnt vmcnt(0)
L_kb:
    buffer_load_dwordx4 v[100:103], v2, s[40:43], s12 offen offset:0 nt
    buffer_load_dwordx4 v[104:107], v2, s[40:43], s12 offen offset:128 nt
    buffer_load_dwordx4 v[108:111], v2, s[40:43], s12 offen offset:256 nt
    s_add_u32 s12, s12, 196608
L_k0:
    s_cmp_eq_u32 s8, 3
    s_cselect_b32 s40, s20, s40
    s_cselect_b32 s41, s21, s41
    s_cselect_b32 s12, s10, s12
    v_dot2_f32_bf16 v10, v64, v40, 0
    v_dot2_f32_bf16 v11, v68, v44, 0
    v_dot2_f32_bf16 v12, v72, v48, 0
    v_dot2_f32_bf16 v10, v65, v41, v10
    v_dot2_f32_bf16 v11, v69, v45, v11
    v_dot2_f32_bf16 v12, v73, v49, v12
    v_dot2_f32_bf16 v10, v66, v42, v10
    v_dot2_f32_bf16 v11, v70, v46, v11
    v_dot2_f32_bf16 v12, v74, v50, v12
    v_dot2_f32_bf16 v10, v67, v43, v10
    v_dot2_f32_bf16 v11, v71, v47, v11
    v_dot2_f32_bf16 v12, v75, v51, v12
    v_cmp_eq_u32 vcc, 0, v15
    v_cmp_eq_u32 s[60:61], -8, v15
    v_add_u32 v15, -1, v15
    v_add_f32 v10, v10, v11
    v_add_f32 v10, v10, v12
    s_nop 1
    v_add_f32_dpp v10, v10, v10 quad_perm:[1,0,3,2] row_mask:0xf bank_mask:0xf
    s_nop 1
    v_add_f32_dpp v10, v10, v10 quad_perm:[2,3,0,1] row_mask:0xf bank_mask:0xf
    s_nop 1
    v_add_f32_dpp v10, v10, v10 row_half_mirror row_mask:0xf bank_mask:0xf
    v_cndmask_b32 v24, v24, v10, vcc
    v_cndmask_b32 v25, v25, v10, s[60:61]
    s_cbranch_scc0 L_kn
    v_pk_mov_b32 v[64:65], v[144:145], v[144:145] op_sel:[0,1]
    v_pk_mov_b32 v[66:67], v[146:147], v[146:147] op_sel:[0,1]
    v_pk_mov_b32 v[68:69], v[148:149], v[148:149] op_sel:[0,1]
    v_pk_mov_b32 v[70:71], v[150:151], v[150:151] op_sel:[0,1]
    v_pk_mov_b32 v[72:73], v[152:153], v[152:153] op_sel:[0,1]
    v_pk_mov_b32 v[74:75], v[154:155], v[154:155] op_sel:[0,1]
    s_add_u32 s12, s12, 196608
    s_branch L_k1
L_kn:
    s_waitcnt vmcnt(0)
    buffer_load_dwordx4 v[64:67], v2, s[40:43], s12 offen offset:0 nt
    buffer_load_dwordx4 v[68:71], v2, s[40:43], s12 offen offset:128 nt
    buffer_load_dwordx4 v[72:75], v2, s[40:43], s12 offen offset:256 nt
    s_add_u32 s12, s12, 196608
L_k1:
    v_dot2_f32_bf16 v10, v76, v40, 0
    v_dot2_f32_bf16 v11, v80, v44, 0
    v_dot2_f32_bf16 v12, v84, v48, 0
    v_dot2_f32_bf16 v10, v77, v41, v10
    v_dot2_f32_bf16 v11, v81, v45, v11
    v_dot2_f32_bf16 v12, v85, v49, v12
    v_dot2_f32_bf16 v10, v78, v42, v10
    v_dot2_f32_bf16 v11, v82, v46, v11
    v_dot2_f32_bf16 v12, v86, v50, v12
    v_dot2_f32_bf16 v10, v79, v43, v10
    v_dot2_f32_bf16 v11, v83, v47, v11
    v_dot2_f32_bf16 v12, v87, v51, v12
    v_cmp_eq_u32 vcc, 0, v15
    v_cmp_eq_u32 s[60:61], -8, v15
    v_add_u32 v15, -1, v15
    v_add_f32 v10, v10, v11
    v_add_f32 v10, v10, v12
    s_nop 1
    v_add_f32_dpp v10, v10, v10 quad_perm:[1,0,3,2] row_mask:0xf bank_mask:0xf
    s_nop 1
    v_add_f32_dpp v10, v10, v10 quad_perm:[2,3,0,1] row_mask:0xf bank_mask:0xf
    s_nop 1
    v_add_f32_dpp v10, v10, v10 row_half_mirror row_mask:0xf bank_mask:0xf
    v_cndmask_b32 v24, v24, v10, vcc
    v_cndmask_b32 v25, v25, v10, s[60:61]
    s_waitcnt vmcnt(0)
    buffer_load_dwordx4 v[76:79], v2, s[40:43], s12 offen offset:0 nt
    buffer_load_dwordx4 v[80:83], v2, s[40:43], s12 offen offset:128 nt
    buffer_load_dwordx4 v[84:87], v2, s[40:43], s12 offen offset:256 nt
    s_add_u32 s12, s12, 196608
L_k2:
    v_dot2_f32_bf16 v10, v88, v40, 0
    v_dot2_f32_bf16 v11, v92, v44, 0
    v_dot2_f32_bf16 v12, v96, v48, 0
    v_dot2_f32_bf16 v10, v89, v41, v10
    v_dot2_f32_bf16 v11, v93, v45, v11
    v_dot2_f32_bf16 v12, v97, v49, v12
    v_dot2_f32_bf16 v10, v90, v42, v10
    v_dot2_f32_bf16 v11, v94, v46, v11
    v_dot2_f32_bf16 v12, v98, v50, v12
    v_dot2_f32_bf16 v10, v91, v43, v10
    v_dot2_f32_bf16 v11, v95, v47, v11
    v_dot2_f32_bf16 v12, v99, v51, v12
    v_cmp_eq_u32 vcc, 0, v15
    v_cmp_eq_u32 s[60:61], -8, v15
    v_add_u32 v15, -1, v15
    v_add_f32 v10, v10, v11
    v_add_f32 v10, v10, v12
    s_nop 1
    v_add_f32_dpp v10, v10, v10 quad_perm:[1,0,3,2] row_mask:0xf bank_mask:0xf
    s_nop 1
    v_add_f32_dpp v10, v10, v10 quad_perm:[2,3,0,1] row_mask:0xf bank_mask:0xf
    s_nop 1
    v_add_f32_dpp v10, v10, v10 row_half_mirror row_mask:0xf bank_mask:0xf
    v_cndmask_b32 v24, v24, v10, vcc
    v_cndmask_b32 v25, v25, v10, s[60:61]
    s_waitcnt vmcnt(0)
    buffer_load_dwordx4 v[88:91], v2, s[40:43], s12 offen offset:0 nt
    buffer_load_dwordx4 v[92:95], v2, s[40:43], s12 offen offset:128 nt
    buffer_load_dwordx4 v[96:99], v2, s[40:43], s12 offen offset:256 nt
    s_add_u32 s12, s12, 196608
L_k3:
    v_dot2_f32_bf16 v10, v100, v40, 0
    v_dot2_f32_bf16 v11, v104, v44, 0
    v_dot2_f32_bf16 v12, v108, v48, 0
    v_dot2_f32_bf16 v10, v101, v41, v10
    v_dot2_f32_bf16 v11, v105, v45, v11
    v_dot2_f32_bf16 v12, v109, v49, v12
    v_dot2_f32_bf16 v10, v102, v42, v10
    v_dot2_f32_bf16 v11, v106, v46, v11
    v_dot2_f32_bf16 v12, v110, v50, v12
    v_dot2_f32_bf16 v10, v103, v43, v10
    v_dot2_f32_bf16 v11, v107, v47, v11
    v_dot2_f32_bf16 v12, v111, v51, v12
    v_cmp_eq_u32 vcc, 0, v15
    v_cmp_eq_u32 s[60:61], -8, v15
    v_add_u32 v15, -1, v15
    v_add_f32 v10, v10, v11
    v_add_f32 v10, v10, v12
    s_nop 1
    v_add_f32_dpp v10, v10, v10 quad_perm:[1,0,3,2] row_mask:0xf bank_mask:0xf
    s_nop 1
    v_add_f32_dpp v10, v10, v10 quad_perm:[2,3,0,1] row_mask:0xf bank_mask:0xf
    s_nop 1
    v_add_f32_dpp v10, v10, v10 row_half_mirror row_mask:0xf bank_mask:0xf
    v_cndmask_b32 v24, v24, v10, vcc
    v_cndmask_b32 v25, v25, v10, s[60:61]
    s_add_u32 s8, s8, 1
    s_cmp_lt_u32 s8, 4
    s_cbranch_scc1 L_kloop
    s_waitcnt vmcnt(0)
L_early:
    buffer_load_dwordx4 v[100:103], v2, s[40:43], s12 offen offset:0 nt
    buffer_load_dwordx4 v[104:107], v2, s[40:43], s12 offen offset:128 nt
    buffer_load_dwordx4 v[108:111], v2, s[40:43], s12 offen offset:256 nt
    s_add_u32 s12, s12, 196608
    v_cvt_pk_bf16_f32 v24, v24, v25
    s_mov_b32 s11, 0x3d93cd3a
    v_and_b32 v25, 0xffff0000, v24
    v_lshlrev_b32 v24, 16, v24
    v_mul_f32 v24, s11, v24
    v_mul_f32 v25, s11, v25
    v_cvt_pk_bf16_f32 v24, v24, v25
    v_and_b32 v25, 0xffff0000, v24
    v_lshlrev_b32 v24, 16, v24
    v_max_f32 v10, v24, v25
    s_mov_b32 s11, 0x3fb8aa3b
    s_nop 0
    v_max_f32_dpp v10, v10, v10 quad_perm:[1,0,3,2] row_mask:0xf bank_mask:0xf
    s_nop 1
    v_max_f32_dpp v10, v10, v10 quad_perm:[2,3,0,1] row_mask:0xf bank_mask:0xf
    s_nop 1
    v_max_f32_dpp v10, v10, v10 row_half_mirror row_mask:0xf bank_mask:0xf
    s_nop 1
    v_max_f32_dpp v10, v10, v10 row_ror:8 row_mask:0xf bank_mask:0xf
    v_mov_b32 v11, v10
    s_nop 1
    v_permlane16_swap_b32 v10, v11
    v_max_f32 v10, v10, v11
    v_mov_b32 v11, v10
    s_nop 1
    v_permlane32_swap_b32 v10, v11
    v_max_f32 v10, v10, v11
    v_mul_f32 v10, s11, v10
    v_fma_f32 v24, v24, s11, -v10
    v_fma_f32 v25, v25, s11, -v10
    v_exp_f32 v24, v24
    v_exp_f32 v25, v25
    v_mov_b32 v40, 0
    v_mov_b32 v41, 0
    v_mov_b32 v42, 0
    v_mov_b32 v43, 0
    v_mov_b32 v44, 0
    v_mov_b32 v45, 0
    v_mov_b32 v46, 0
    v_mov_b32 v47, 0
    v_mov_b32 v48, 0
    v_mov_b32 v49, 0
    v_mov_b32 v50, 0
    v_mov_b32 v51, 0
    v_add_f32 v11, v24, v25
    v_cvt_pk_bf16_f32 v24, v24, v24
    v_cvt_pk_bf16_f32 v25, v25, v25
    v_add_f32_dpp v11, v11, v11 quad_perm:[1,0,3,2] row_mask:0xf bank_mask:0xf
    s_nop 1
    v_add_f32_dpp v11, v11, v11 quad_perm:[2,3,0,1] row_mask:0xf bank_mask:0xf
    s_nop 1
    v_add_f32_dpp v11, v11, v11 row_half_mirror row_mask:0xf bank_mask:0xf
    s_nop 1
    v_add_f32_dpp v11, v11, v11 row_ror:8 row_mask:0xf bank_mask:0xf
    v_mov_b32 v12, v11
    s_nop 1
    v_permlane16_swap_b32 v11, v12
    v_add_f32 v11, v11, v12
    v_mov_b32 v12, v11
    s_nop 1
    v_permlane32_swap_b32 v11, v12
    v_add_f32 v11, v11, v12
    s_lshl_b32 s11, s6, 3
    v_mov_b32 v9, s11
    s_mov_b32 s8, 0
    s_mov_b32 s13, 600000
    ds_write_b64 v9, v[10:11] offset:15744
    s_branch L_v0
L_vloop:
    s_cmp_eq_u32 s8, 3
    s_cbranch_scc1 L_vb0
    s_waitcnt vmcnt(0)
L_vb0:
    buffer_load_dwordx4 v[100:103], v2, s[40:43], s12 offen offset:0 nt
    buffer_load_dwordx4 v[104:107], v2, s[40:43], s12 offen offset:128 nt
    buffer_load_dwordx4 v[108:111], v2, s[40:43], s12 offen offset:256 nt
    s_add_u32 s12, s12, 196608
L_v0:
    v_mov_b32_dpp v26, v24 row_newbcast:0 row_mask:0xf bank_mask:0x3
    s_nop 1
    v_mov_b32_dpp v26, v24 row_newbcast:8 row_mask:0xf bank_mask:0xc
    v_and_b32 v28, v26, v140
    v_and_b32 v29, v26, v141
    v_and_b32 v30, v26, v142
    v_and_b32 v31, v26, v143
    s_nop 1
    v_mfma_f32_16x16x32_bf16 v[40:43], v[28:31], v[64:67], v[40:43]
    v_mfma_f32_16x16x32_bf16 v[44:47], v[28:31], v[68:71], v[44:47]
    v_mfma_f32_16x16x32_bf16 v[48:51], v[28:31], v[72:75], v[48:51]
    v_mov_b32_dpp v26, v24 row_newbcast:1 row_mask:0xf bank_mask:0x3
    s_nop 1
    v_mov_b32_dpp v26, v24 row_newbcast:9 row_mask:0xf bank_mask:0xc
    v_and_b32 v32, v26, v140
    v_and_b32 v33, v26, v141
    v_and_b32 v34, v26, v142
    v_and_b32 v35, v26, v143
    s_cmp_eq_u32 s8, 3
    s_cbranch_scc1 L_last
    s_waitcnt vmcnt(0)
    buffer_load_dwordx4 v[64:67], v2, s[40:43], s12 offen offset:0 nt
    buffer_load_dwordx4 v[68:71], v2, s[40:43], s12 offen offset:128 nt
    buffer_load_dwordx4 v[72:75], v2, s[40:43], s12 offen offset:256 nt
    s_add_u32 s12, s12, 196608
    v_mfma_f32_16x16x32_bf16 v[40:43], v[32:35], v[76:79], v[40:43]
    v_mfma_f32_16x16x32_bf16 v[44:47], v[32:35], v[80:83], v[44:47]
    v_mfma_f32_16x16x32_bf16 v[48:51], v[32:35], v[84:87], v[48:51]
    v_mov_b32_dpp v26, v24 row_newbcast:2 row_mask:0xf bank_mask:0x3
    s_nop 1
    v_mov_b32_dpp v26, v24 row_newbcast:10 row_mask:0xf bank_mask:0xc
    v_and_b32 v28, v26, v140
    v_and_b32 v29, v26, v141
    v_and_b32 v30, v26, v142
    v_and_b32 v31, v26, v143
    s_waitcnt vmcnt(0)
    buffer_load_dwordx4 v[76:79], v2, s[40:43], s12 offen offset:0 nt
    buffer_load_dwordx4 v[80:83], v2, s[40:43], s12 offen offset:128 nt
    buffer_load_dwordx4 v[84:87], v2, s[40:43], s12 offen offset:256 nt
    s_add_u32 s12, s12, 196608
    v_mfma_f32_16x16x32_bf16 v[40:43], v[28:31], v[88:91], v[40:43]
    v_mfma_f32_16x16x32_bf16 v[44:47], v[28:31], v[92:95], v[44:47]
    v_mfma_f32_16x16x32_bf16 v[48:51], v[28:31], v[96:99], v[48:51]
    v_mov_b32_dpp v26, v24 row_newbcast:3 row_mask:0xf bank_mask:0x3
    s_nop 1
    v_mov_b32_dpp v26, v24 row_newbcast:11 row_mask:0xf bank_mask:0xc
    v_and_b32 v32, v26, v140
    v_and_b32 v33, v26, v141
    v_and_b32 v34, v26, v142
    v_and_b32 v35, v26, v143
    s_cmp_eq_u32 s8, 2
    s_cbranch_scc1 L_vb3
    s_waitcnt vmcnt(0)
L_vb3:
    buffer_load_dwordx4 v[88:91], v2, s[40:43], s12 offen offset:0 nt
    buffer_load_dwordx4 v[92:95], v2, s[40:43], s12 offen offset:128 nt
    buffer_load_dwordx4 v[96:99], v2, s[40:43], s12 offen offset:256 nt
    s_add_u32 s12, s12, 196608
    v_mfma_f32_16x16x32_bf16 v[40:43], v[32:35], v[100:103], v[40:43]
    v_mfma_f32_16x16x32_bf16 v[44:47], v[32:35], v[104:107], v[44:47]
    v_mfma_f32_16x16x32_bf16 v[48:51], v[32:35], v[108:111], v[48:51]
    v_mov_b32_dpp v24, v24 row_shl:4 row_mask:0xf bank_mask:0xf bound_ctrl:0
    s_add_u32 s8, s8, 1
    s_cmp_lg_u32 s8, 2
    s_cbranch_scc1 L_vloop
    v_mov_b32 v24, v25
    ds_write_b32 v16, v16 offset:15812
    s_branch L_vloop
L_last:
    v_mov_b32_dpp v26, v24 row_newbcast:2 row_mask:0xf bank_mask:0x3
    s_nop 1
    v_mov_b32_dpp v26, v24 row_newbcast:10 row_mask:0xf bank_mask:0xc
    v_and_b32 v28, v26, v140
    v_and_b32 v29, v26, v141
    v_and_b32 v30, v26, v142
    v_and_b32 v31, v26, v143
    v_mov_b32_dpp v26, v24 row_newbcast:3 row_mask:0xf bank_mask:0x3
    s_nop 1
    v_mov_b32_dpp v26, v24 row_newbcast:11 row_mask:0xf bank_mask:0xc
    v_and_b32 v36, v26, v140
    v_and_b32 v37, v26, v141
    v_and_b32 v38, v26, v142
    v_and_b32 v39, v26, v143
    s_barrier
    s_add_u32 s11, s54, 7680
    buffer_load_dword v124, v27, s[64:67], s11 offen offset:2560 nt
    s_add_u32 s11, s54, 11520
    buffer_load_dword v125, v27, s[64:67], s11 offen offset:2560 nt
    s_add_u32 s11, s54, 15360
    buffer_load_dword v126, v27, s[64:67], s11 offen offset:0 nt
    buffer_load_dword v127, v27, s[64:67], s11 offen offset:1280 nt
    buffer_load_dword v130, v27, s[64:67], s11 offen offset:2560 nt
    s_add_u32 s11, s54, 19200
    buffer_load_dword v128, v27, s[64:67], s11 offen offset:0 nt
    buffer_load_dword v129, v27, s[64:67], s11 offen offset:1280 nt
    buffer_load_dword v131, v27, s[64:67], s11 offen offset:2560 nt
    s_add_u32 s11, s54, 23040
    buffer_load_dword v132, v27, s[64:67], s11 offen offset:0 nt
    buffer_load_dword v133, v27, s[64:67], s11 offen offset:1280 nt
    buffer_load_dword v136, v27, s[64:67], s11 offen offset:2560 nt
    s_add_u32 s11, s54, 26880
    buffer_load_dword v134, v27, s[64:67], s11 offen offset:0 nt
    buffer_load_dword v135, v27, s[64:67], s11 offen offset:1280 nt
    buffer_load_dword v137, v27, s[64:67], s11 offen offset:2560 nt
    s_waitcnt vmcnt(20)
    v_mfma_f32_16x16x32_bf16 v[40:43], v[32:35], v[76:79], v[40:43]
    v_mfma_f32_16x16x32_bf16 v[44:47], v[32:35], v[80:83], v[44:47]
    v_mfma_f32_16x16x32_bf16 v[48:51], v[32:35], v[84:87], v[48:51]
    s_waitcnt vmcnt(17)
    v_mfma_f32_16x16x32_bf16 v[40:43], v[28:31], v[88:91], v[40:43]
    v_mfma_f32_16x16x32_bf16 v[44:47], v[28:31], v[92:95], v[44:47]
    v_mfma_f32_16x16x32_bf16 v[48:51], v[28:31], v[96:99], v[48:51]
    s_waitcnt vmcnt(14)
    v_mfma_f32_16x16x32_bf16 v[40:43], v[36:39], v[100:103], v[40:43]
    v_mfma_f32_16x16x32_bf16 v[44:47], v[36:39], v[104:107], v[44:47]
    v_mfma_f32_16x16x32_bf16 v[48:51], v[36:39], v[108:111], v[48:51]
    s_nop 5
    v_permlane32_swap_b32 v40, v42
    v_permlane32_swap_b32 v41, v43
    v_permlane32_swap_b32 v44, v46
    v_permlane32_swap_b32 v45, v47
    v_permlane32_swap_b32 v48, v50
    v_permlane32_swap_b32 v49, v51
    v_add_f32_dpp v12, v42, v40 row_ror:8 row_mask:0xf bank_mask:0x3
    v_add_f32_dpp v13, v46, v44 row_ror:8 row_mask:0xf bank_mask:0x3
    v_add_f32_dpp v14, v50, v48 row_ror:8 row_mask:0xf bank_mask:0x3
    v_add_f32_dpp v12, v41, v43 row_ror:8 row_mask:0xf bank_mask:0xc
    v_add_f32_dpp v13, v45, v47 row_ror:8 row_mask:0xf bank_mask:0xc
    v_add_f32_dpp v14, v49, v51 row_ror:8 row_mask:0xf bank_mask:0xc
    ds_write_b32 v20, v12 offset:16384
    ds_write_b32 v21, v13 offset:16384
    ds_write_b32 v22, v14 offset:16384
    s_waitcnt lgkmcnt(0)
    s_barrier
    s_waitcnt vmcnt(0)
    buffer_load_dwordx4 v[28:31], v0, s[56:59], s7 offen sc1
    v_perm_b32 v122, v125, v124, s52
    v_perm_b32 v123, v125, v124, s53
    v_perm_b32 v124, v127, v126, s52
    v_perm_b32 v125, v127, v126, s53
    v_perm_b32 v126, v129, v128, s52
    v_perm_b32 v127, v129, v128, s53
    v_perm_b32 v128, v131, v130, s52
    v_perm_b32 v129, v131, v130, s53
    v_perm_b32 v130, v133, v132, s52
    v_perm_b32 v131, v133, v132, s53
    v_perm_b32 v132, v135, v134, s52
    v_perm_b32 v133, v135, v134, s53
    v_perm_b32 v134, v137, v136, s52
    v_perm_b32 v135, v137, v136, s53
    s_branch L_p2_w
L_p2:
    buffer_load_dwordx4 v[28:31], v0, s[56:59], s7 offen sc1
L_p2_w:
    s_waitcnt vmcnt(0)
    v_cmp_ne_u32 vcc, s55, v31
    s_cbranch_vccz L_p2_ok0
    s_sub_u32 s13, s13, 1
    s_cbranch_scc0 L_p2
L_p2_ok0:
    v_mov_b32 v31, v30
    v_permlane32_swap_b32 v28, v29
    v_add_f32 v12, v28, v29
    v_permlane32_swap_b32 v30, v31
    v_add_f32 v13, v30, v31
L_p2_done:
    v_mov_b32 v14, v12
    v_mov_b32 v15, v13
    s_nop 0
    v_permlane16_swap_b32 v12, v14
    v_permlane16_swap_b32 v13, v15
    v_add_f32 v12, v12, v14
    v_add_f32 v13, v13, v15
    s_nop 0
    v_add_f32_dpp v12, v12, v12 row_ror:8 row_mask:0xf bank_mask:0xf
    v_add_f32_dpp v13, v13, v13 row_ror:8 row_mask:0xf bank_mask:0xf
    v_mov_b32 v14, v12
    s_nop 0
    v_mov_b32_dpp v15, v13 quad_perm:[1,0,3,2] row_mask:0xf bank_mask:0xf
    v_permlane32_swap_b32 v12, v14
    v_cvt_pk_bf16_f32 v13, v13, v15
    v_cvt_pk_bf16_f32 v12, v12, v14
    s_nop 0
    v_dot2c_f32_bf16_dpp v16, v13, v116 row_newbcast:0 row_mask:0xf bank_mask:0xf
    v_dot2c_f32_bf16_dpp v17, v13, v117 row_newbcast:0 row_mask:0xf bank_mask:0xf
    v_dot2c_f32_bf16_dpp v18, v13, v122 row_newbcast:2 row_mask:0xf bank_mask:0xf
    v_dot2c_f32_bf16_dpp v19, v13, v123 row_newbcast:2 row_mask:0xf bank_mask:0xf
    v_dot2c_f32_bf16_dpp v16, v13, v128 row_newbcast:4 row_mask:0xf bank_mask:0xf
    v_dot2c_f32_bf16_dpp v17, v13, v129 row_newbcast:4 row_mask:0xf bank_mask:0xf
    v_dot2c_f32_bf16_dpp v18, v13, v134 row_newbcast:6 row_mask:0xf bank_mask:0xf
    v_dot2c_f32_bf16_dpp v19, v13, v135 row_newbcast:6 row_mask:0xf bank_mask:0xf
    v_dot2c_f32_bf16_dpp v16, v12, v112 row_newbcast:0 row_mask:0xf bank_mask:0xf
    v_dot2c_f32_bf16_dpp v17, v12, v113 row_newbcast:0 row_mask:0xf bank_mask:0xf
    v_dot2c_f32_bf16_dpp v18, v12, v114 row_newbcast:1 row_mask:0xf bank_mask:0xf
    v_dot2c_f32_bf16_dpp v19, v12, v115 row_newbcast:1 row_mask:0xf bank_mask:0xf
    v_dot2c_f32_bf16_dpp v16, v12, v118 row_newbcast:2 row_mask:0xf bank_mask:0xf
    v_dot2c_f32_bf16_dpp v17, v12, v119 row_newbcast:2 row_mask:0xf bank_mask:0xf
    v_dot2c_f32_bf16_dpp v18, v12, v120 row_newbcast:3 row_mask:0xf bank_mask:0xf
    v_dot2c_f32_bf16_dpp v19, v12, v121 row_newbcast:3 row_mask:0xf bank_mask:0xf
    v_dot2c_f32_bf16_dpp v16, v12, v124 row_newbcast:4 row_mask:0xf bank_mask:0xf
    v_dot2c_f32_bf16_dpp v17, v12, v125 row_newbcast:4 row_mask:0xf bank_mask:0xf
    v_dot2c_f32_bf16_dpp v18, v12, v126 row_newbcast:5 row_mask:0xf bank_mask:0xf
    v_dot2c_f32_bf16_dpp v19, v12, v127 row_newbcast:5 row_mask:0xf bank_mask:0xf
    v_dot2c_f32_bf16_dpp v16, v12, v130 row_newbcast:6 row_mask:0xf bank_mask:0xf
    v_dot2c_f32_bf16_dpp v17, v12, v131 row_newbcast:6 row_mask:0xf bank_mask:0xf
    v_dot2c_f32_bf16_dpp v18, v12, v132 row_newbcast:7 row_mask:0xf bank_mask:0xf
    v_dot2c_f32_bf16_dpp v19, v12, v133 row_newbcast:7 row_mask:0xf bank_mask:0xf
    s_mov_b32 s13, 600000
    s_cmp_lg_u32 s63, 0
    s_nop 0
    v_pk_add_f32 v[16:17], v[16:17], v[18:19]
    ds_write_b32 v3, v16 offset:24576
    ds_write_b32 v4, v17 offset:24576
    s_waitcnt lgkmcnt(0)
    s_barrier
    s_cbranch_scc1 L_fin
L_p3:
    buffer_load_dwordx4 v[64:67], v7, s[56:59], s14 offen sc1
    buffer_load_dwordx4 v[68:71], v7, s[56:59], s15 offen sc1
L_p3_w:
    s_waitcnt vmcnt(0)
    v_cmp_ne_u32 vcc, s62, v67
    v_cmp_ne_u32 s[60:61], s62, v71
    s_or_b64 vcc, vcc, s[60:61]
    s_cbranch_vccz L_p3_ok0
    s_sub_u32 s13, s13, 1
    s_cbranch_scc0 L_p3
L_p3_ok0:
    v_pk_add_f32 v[12:13], v[64:65], v[68:69]
    v_pk_add_f32 v[14:15], v[66:67], v[70:71]
L_p3_done:
    s_nop 1
    v_permlane32_swap_b32 v12, v14
    v_permlane32_swap_b32 v13, v15
    v_pk_add_f32 v[12:13], v[12:13], v[14:15]
    s_nop 1
    v_permlane16_swap_b32 v12, v13
    v_add_f32 v12, v12, v13
    s_nop 1
    v_add_f32_dpp v12, v12, v12 row_ror:4 row_mask:0xf bank_mask:0xf
    s_nop 1
    v_add_f32_dpp v12, v12, v12 row_ror:8 row_mask:0xf bank_mask:0xf
    v_add_f32 v12, v12, v8
    v_cvt_pk_bf16_f32 v12, v12, v12
    s_mov_b64 exec, s[48:49]
    buffer_store_short v12, v23, s[72:75], s9 offen
    s_or_b32 s11, s5, s6
    s_cbranch_scc1 L_fin
    s_mov_b64 exec, 1
    v_mov_b32 v9, s62
    s_mov_b32 s11, 950272
    buffer_store_dword v9, off, s[56:59], s11
    s_branch L_fin
L_ctl:
    v_mov_b32 v20, -1
    s_lshl_b32 s7, s4, 13
    s_lshl_b32 s12, s5, 7
    s_add_u32 s7, s7, s12
    s_add_u32 s7, s7, 524288
    s_lshl_b32 s8, s3, 9
    s_add_u32 s8, s8, 786432
    v_lshl_add_u32 v2, v4, 10, v5
    ds_write_b32 v6, v20 offset:15744
    s_add_u32 s60, s38, 950272
    s_addc_u32 s61, s39, 0
    s_load_dword s62, s[60:61], 0
    s_mov_b32 s56, s38
    s_mov_b32 s57, s39
    s_mov_b32 s58, 2621440
    s_mov_b32 s59, 0x20000
    s_mov_b32 s68, s32
    s_mov_b32 s69, s33
    s_mov_b32 s70, 1966080
    s_mov_b32 s71, 0x20000
    s_getreg_b32 s55, hwreg(HW_REG_XCC_ID)
    s_and_b32 s55, s55, 15
    s_waitcnt vmcnt(0)
    v_lshlrev_b32 v24, 16, v10
    v_and_b32 v25, 0xffff0000, v10
    v_lshlrev_b32 v26, 16, v11
    v_and_b32 v27, 0xffff0000, v11
    v_lshlrev_b32 v28, 16, v12
    v_and_b32 v29, 0xffff0000, v12
    v_lshlrev_b32 v30, 16, v13
    v_and_b32 v31, 0xffff0000, v13
    v_lshlrev_b32 v32, 16, v14
    v_and_b32 v33, 0xffff0000, v14
    v_pk_add_f32 v[16:17], v[24:25], v[26:27]
    v_pk_add_f32 v[18:19], v[28:29], v[30:31]
    v_pk_add_f32 v[16:17], v[16:17], v[32:33]
    v_pk_add_f32 v[16:17], v[16:17], v[18:19]
    v_add_f32 v17, v16, v17
    s_nop 1
    v_add_f32_dpp v17, v17, v17 quad_perm:[1,0,3,2] row_mask:0xf bank_mask:0xf
    s_nop 1
    v_add_f32_dpp v17, v17, v17 quad_perm:[2,3,0,1] row_mask:0xf bank_mask:0xf
    s_nop 1
    v_add_f32_dpp v17, v17, v17 row_half_mirror row_mask:0xf bank_mask:0xf
    s_nop 1
    v_add_f32_dpp v17, v17, v17 row_ror:8 row_mask:0xf bank_mask:0xf
    v_mov_b32 v18, v17
    s_nop 1
    v_permlane16_swap_b32 v17, v18
    v_add_f32 v17, v17, v18
    v_mov_b32 v18, v17
    s_nop 1
    v_permlane32_swap_b32 v17, v18
    v_add_f32 v17, v17, v18
    v_mul_f32 v17, 0x3acccccd, v17
    v_sub_f32 v34, v24, v17
    v_sub_f32 v35, v25, v17
    v_sub_f32 v36, v26, v17
    v_sub_f32 v37, v27, v17
    v_sub_f32 v38, v28, v17
    v_sub_f32 v39, v29, v17
    v_sub_f32 v40, v30, v17
    v_sub_f32 v41, v31, v17
    v_sub_f32 v42, v32, v17
    v_sub_f32 v43, v33, v17
    v_pk_mul_f32 v[18:19], v[34:35], v[34:35]
    v_pk_fma_f32 v[18:19], v[36:37], v[36:37], v[18:19]
    v_pk_fma_f32 v[18:19], v[38:39], v[38:39], v[18:19]
    v_pk_fma_f32 v[18:19], v[40:41], v[40:41], v[18:19]
    v_pk_fma_f32 v[18:19], v[42:43], v[42:43], v[18:19]
    v_add_f32 v18, v18, v19
    v_cvt_pk_bf16_f32 v17, v17, v17
    v_lshlrev_b32 v17, 16, v17
    v_add_f32_dpp v18, v18, v18 quad_perm:[1,0,3,2] row_mask:0xf bank_mask:0xf
    s_nop 1
    v_add_f32_dpp v18, v18, v18 quad_perm:[2,3,0,1] row_mask:0xf bank_mask:0xf
    s_nop 1
    v_add_f32_dpp v18, v18, v18 row_half_mirror row_mask:0xf bank_mask:0xf
    s_nop 1
    v_add_f32_dpp v18, v18, v18 row_ror:8 row_mask:0xf bank_mask:0xf
    v_mov_b32 v19, v18
    s_nop 1
    v_permlane16_swap_b32 v18, v19
    v_add_f32 v18, v18, v19
    v_mov_b32 v19, v18
    s_nop 1
    v_permlane32_swap_b32 v18, v19
    v_add_f32 v18, v18, v19
    v_mul_f32 v18, 0x3acccccd, v18
    v_cvt_pk_bf16_f32 v18, v18, v18
    v_lshlrev_b32 v18, 16, v18
    v_add_f32 v18, 0x3727c5ac, v18
    v_cvt_pk_bf16_f32 v18, v18, v18
    v_lshlrev_b32 v18, 16, v18
    v_sqrt_f32 v18, v18
    v_sub_f32 v24, v24, v17
    v_sub_f32 v25, v25, v17
    v_sub_f32 v26, v26, v17
    v_sub_f32 v27, v27, v17
    v_sub_f32 v28, v28, v17
    v_sub_f32 v29, v29, v17
    v_sub_f32 v30, v30, v17
    v_sub_f32 v31, v31, v17
    v_sub_f32 v32, v32, v17
    v_sub_f32 v33, v33, v17
    v_cvt_pk_bf16_f32 v18, v18, v18
    v_lshlrev_b32 v18, 16, v18
    v_rcp_f32 v20, v18
    v_xor_b32 v18, 0x80000000, v18
    v_mov_b32 v19, v18
    v_cvt_pk_bf16_f32 v44, v24, v25
    v_cvt_pk_bf16_f32 v45, v26, v27
    v_cvt_pk_bf16_f32 v46, v28, v29
    v_cvt_pk_bf16_f32 v47, v30, v31
    v_cvt_pk_bf16_f32 v48, v32, v33
    v_mov_b32 v21, v20
    v_lshlrev_b32 v24, 16, v44
    v_and_b32 v25, 0xffff0000, v44
    v_lshlrev_b32 v26, 16, v45
    v_and_b32 v27, 0xffff0000, v45
    v_lshlrev_b32 v28, 16, v46
    v_and_b32 v29, 0xffff0000, v46
    v_lshlrev_b32 v30, 16, v47
    v_and_b32 v31, 0xffff0000, v47
    v_lshlrev_b32 v32, 16, v48
    v_and_b32 v33, 0xffff0000, v48
    v_pk_mul_f32 v[34:35], v[24:25], v[20:21]
    v_pk_mul_f32 v[36:37], v[26:27], v[20:21]
    v_pk_mul_f32 v[38:39], v[28:29], v[20:21]
    v_pk_mul_f32 v[40:41], v[30:31], v[20:21]
    v_pk_mul_f32 v[42:43], v[32:33], v[20:21]
    v_pk_fma_f32 v[24:25], v[34:35], v[18:19], v[24:25]
    v_pk_fma_f32 v[26:27], v[36:37], v[18:19], v[26:27]
    v_pk_fma_f32 v[28:29], v[38:39], v[18:19], v[28:29]
    v_pk_fma_f32 v[30:31], v[40:41], v[18:19], v[30:31]
    v_pk_fma_f32 v[32:33], v[42:43], v[18:19], v[32:33]
    v_pk_fma_f32 v[34:35], v[24:25], v[20:21], v[34:35]
    v_pk_fma_f32 v[36:37], v[26:27], v[20:21], v[36:37]
    v_pk_fma_f32 v[38:39], v[28:29], v[20:21], v[38:39]
    v_pk_fma_f32 v[40:41], v[30:31], v[20:21], v[40:41]
    v_pk_fma_f32 v[42:43], v[32:33], v[20:21], v[42:43]
    v_cvt_pk_bf16_f32 v44, v34, v35
    v_cvt_pk_bf16_f32 v45, v36, v37
    v_cvt_pk_bf16_f32 v46, v38, v39
    v_cvt_pk_bf16_f32 v47, v40, v41
    v_cvt_pk_bf16_f32 v48, v42, v43
    ds_write_b32 v6, v44 offset:12288
    ds_write_b32 v6, v45 offset:12544
    ds_write_b32 v6, v46 offset:12800
    ds_write_b32 v6, v47 offset:13056
    ds_write_b32 v6, v48 offset:13312
    s_waitcnt lgkmcnt(0)
    s_barrier
    ds_write_b32 v6, v10 offset:13568
    ds_write_b32 v6, v11 offset:13824
    ds_write_b32 v6, v12 offset:14080
    ds_write_b32 v6, v13 offset:14336
    ds_write_b32 v6, v14 offset:14592
    s_add_u32 s62, s62, 0x9e3779b1
    s_add_u32 s54, s62, s55
    s_lshl_b32 s53, s3, 11
    s_add_u32 s52, s53, 2097152
    s_lshl_b32 s14, s4, 14
    s_add_u32 s14, s14, 2097152
    s_mov_b32 s13, 600000
    v_bfe_u32 v7, v1, 3, 1
    v_bfe_u32 v9, v1, 4, 1
    v_lshl_add_u32 v7, v9, 2, v7
    v_lshrrev_b32 v9, 5, v1
    v_lshl_add_u32 v7, v9, 1, v7
    v_lshl_add_u32 v7, v7, 1, v5
    v_lshrrev_b32 v21, 1, v0
    s_mul_i32 s9, s63, 61440
    s_mul_i32 s12, s5, 160
    s_add_u32 s9, s9, s12
    v_cmp_lt_u32 vcc, 39, v1
    v_mov_b32 v9, 0x7ff00000
    s_nop 0
    v_cndmask_b32 v8, v6, v9, vcc
    v_lshlrev_b32 v9, 1, v1
    v_mul_u32_u24 v10, 171, v9
    v_lshrrev_b32 v10, 9, v10
    v_add_lshl_u32 v3, v9, v10, 2
    v_add_u32 v9, 1, v9
    v_mul_u32_u24 v10, 171, v9
    v_lshrrev_b32 v10, 9, v10
    v_add_lshl_u32 v4, v9, v10, 2
    v_add_u32 v3, 8192, v3
    v_add_u32 v4, 8192, v4
    s_waitcnt lgkmcnt(0)
    s_barrier
    ds_read_b128 v[96:99], v0 offset:0
    ds_read_b128 v[100:103], v0 offset:1024
    ds_read_b128 v[104:107], v0 offset:2048
    ds_read_b128 v[108:111], v0 offset:3072
    ds_read_b128 v[112:115], v0 offset:4096
    ds_read_b128 v[116:119], v0 offset:5120
    ds_read_b128 v[120:123], v0 offset:6144
    ds_read_b128 v[124:127], v0 offset:7168
    ds_read_b64 v[128:129], v21 offset:8192
    ds_read_b64 v[132:133], v21 offset:8704
    ds_read_b64 v[136:137], v21 offset:9216
    ds_read_b64 v[140:141], v21 offset:9728
    ds_read_b64 v[144:145], v21 offset:10240
    ds_read_b64 v[148:149], v21 offset:10752
    ds_read_b64 v[152:153], v21 offset:11264
    ds_read_b64 v[156:157], v21 offset:11776
    v_mov_b32 v30, s54
    v_mov_b32 v31, s54
    s_waitcnt lgkmcnt(8)
    v_pk_add_f32 v[96:97], v[96:97], v[100:101]
    v_pk_add_f32 v[98:99], v[98:99], v[102:103]
    v_pk_add_f32 v[104:105], v[104:105], v[108:109]
    v_pk_add_f32 v[106:107], v[106:107], v[110:111]
    v_pk_add_f32 v[112:113], v[112:113], v[116:117]
    v_pk_add_f32 v[114:115], v[114:115], v[118:119]
    v_pk_add_f32 v[120:121], v[120:121], v[124:125]
    v_pk_add_f32 v[122:123], v[122:123], v[126:127]
    v_pk_add_f32 v[96:97], v[96:97], v[104:105]
    v_pk_add_f32 v[98:99], v[98:99], v[106:107]
    v_pk_add_f32 v[112:113], v[112:113], v[120:121]
    v_pk_add_f32 v[114:115], v[114:115], v[122:123]
    v_pk_add_f32 v[96:97], v[96:97], v[112:113]
    v_pk_add_f32 v[98:99], v[98:99], v[114:115]
    v_mov_b32 v24, v96
    v_mov_b32 v25, v97
    v_mov_b32 v26, v98
    v_mov_b32 v27, s54
    s_waitcnt lgkmcnt(0)
    buffer_store_dwordx4 v[24:27], v0, s[56:59], s52 offen
    v_pk_add_f32 v[128:129], v[128:129], v[132:133]
    v_pk_add_f32 v[136:137], v[136:137], v[140:141]
    v_pk_add_f32 v[144:145], v[144:145], v[148:149]
    v_pk_add_f32 v[152:153], v[152:153], v[156:157]
    v_pk_add_f32 v[128:129], v[128:129], v[136:137]
    v_pk_add_f32 v[144:145], v[144:145], v[152:153]
    v_pk_add_f32 v[128:129], v[128:129], v[144:145]
    v_mov_b32 v28, v128
    v_mov_b32 v29, v129
    buffer_store_dwordx4 v[28:31], v0, s[56:59], s52 offen offset:1024
    buffer_load_dword v42, v8, s[68:71], s9 offen offset:0 nt
    buffer_load_dword v43, v8, s[68:71], s9 offen offset:1280 nt
    buffer_load_dword v44, v8, s[68:71], s9 offen offset:2560 nt
    s_add_u32 s9, s9, 3840
    buffer_load_dword v45, v8, s[68:71], s9 offen offset:0 nt
    buffer_load_dword v46, v8, s[68:71], s9 offen offset:1280 nt
    buffer_load_dword v47, v8, s[68:71], s9 offen offset:2560 nt
    s_add_u32 s9, s9, 3840
    buffer_load_dword v48, v8, s[68:71], s9 offen offset:0 nt
    buffer_load_dword v49, v8, s[68:71], s9 offen offset:1280 nt
    buffer_load_dword v50, v8, s[68:71], s9 offen offset:2560 nt
    s_add_u32 s9, s9, 3840
    buffer_load_dword v51, v8, s[68:71], s9 offen offset:0 nt
    buffer_load_dword v52, v8, s[68:71], s9 offen offset:1280 nt
    buffer_load_dword v53, v8, s[68:71], s9 offen offset:2560 nt
    s_add_u32 s9, s9, 3840
    buffer_load_dword v54, v8, s[68:71], s9 offen offset:0 nt
    buffer_load_dword v55, v8, s[68:71], s9 offen offset:1280 nt
    buffer_load_dword v56, v8, s[68:71], s9 offen offset:2560 nt
    s_add_u32 s9, s9, 3840
    buffer_load_dword v57, v8, s[68:71], s9 offen offset:0 nt
    buffer_load_dword v58, v8, s[68:71], s9 offen offset:1280 nt
    buffer_load_dword v59, v8, s[68:71], s9 offen offset:2560 nt
    s_add_u32 s9, s9, 3840
    buffer_load_dword v60, v8, s[68:71], s9 offen offset:0 nt
    buffer_load_dword v61, v8, s[68:71], s9 offen offset:1280 nt
    buffer_load_dword v62, v8, s[68:71], s9 offen offset:2560 nt
    s_add_u32 s9, s9, 3840
    buffer_load_dword v63, v8, s[68:71], s9 offen offset:0 nt
    buffer_load_dword v64, v8, s[68:71], s9 offen offset:1280 nt
    buffer_load_dword v65, v8, s[68:71], s9 offen offset:2560 nt
    s_add_u32 s9, s9, 3840
    buffer_load_dword v66, v8, s[68:71], s9 offen offset:0 nt
    buffer_load_dword v67, v8, s[68:71], s9 offen offset:1280 nt
    buffer_load_dword v68, v8, s[68:71], s9 offen offset:2560 nt
    s_add_u32 s9, s9, 3840
    buffer_load_dword v69, v8, s[68:71], s9 offen offset:0 nt
    buffer_load_dword v70, v8, s[68:71], s9 offen offset:1280 nt
    buffer_load_dword v71, v8, s[68:71], s9 offen offset:2560 nt
    s_add_u32 s9, s9, 3840
    buffer_load_dword v72, v8, s[68:71], s9 offen offset:0 nt
    buffer_load_dword v73, v8, s[68:71], s9 offen offset:1280 nt
    buffer_load_dword v74, v8, s[68:71], s9 offen offset:2560 nt
    s_add_u32 s9, s9, 3840
    buffer_load_dword v75, v8, s[68:71], s9 offen offset:0 nt
    buffer_load_dword v76, v8, s[68:71], s9 offen offset:1280 nt
    buffer_load_dword v77, v8, s[68:71], s9 offen offset:2560 nt
    s_add_u32 s9, s9, 3840
    buffer_load_dword v78, v8, s[68:71], s9 offen offset:0 nt
    buffer_load_dword v79, v8, s[68:71], s9 offen offset:1280 nt
    buffer_load_dword v80, v8, s[68:71], s9 offen offset:2560 nt
    s_add_u32 s9, s9, 3840
    buffer_load_dword v81, v8, s[68:71], s9 offen offset:0 nt
    buffer_load_dword v82, v8, s[68:71], s9 offen offset:1280 nt
    buffer_load_dword v83, v8, s[68:71], s9 offen offset:2560 nt
    s_add_u32 s9, s9, 3840
    buffer_load_dword v84, v8, s[68:71], s9 offen offset:0 nt
    buffer_load_dword v85, v8, s[68:71], s9 offen offset:1280 nt
    buffer_load_dword v86, v8, s[68:71], s9 offen offset:2560 nt
    s_add_u32 s9, s9, 3840
    buffer_load_dword v87, v8, s[68:71], s9 offen offset:0 nt
    buffer_load_dword v88, v8, s[68:71], s9 offen offset:1280 nt
    buffer_load_dword v89, v8, s[68:71], s9 offen offset:2560 nt
    s_waitcnt vmcnt(0)
    s_branch L_q1
L_pollq:
    s_and_b32 s12, s13, 1
    s_cselect_b32 s11, 2097152, 0
    s_lshl_b32 s14, s4, 14
    s_add_u32 s14, s14, s11
    s_cmp_lg_u32 s13, 599999
    s_cbranch_scc1 L_q1
    buffer_store_dwordx4 v[24:27], v0, s[56:59], s53 offen sc1
    buffer_store_dwordx4 v[28:31], v0, s[56:59], s53 offen offset:1024 sc1
L_q1:
    s_mov_b32 s11, s14
    buffer_load_dwordx4 v[96:99], v0, s[56:59], s11 offen offset:0 sc1
    buffer_load_dwordx4 v[128:131], v0, s[56:59], s11 offen offset:1024 sc1
    buffer_load_dwordx4 v[100:103], v0, s[56:59], s11 offen offset:2048 sc1
    buffer_load_dwordx4 v[132:135], v0, s[56:59], s11 offen offset:3072 sc1
    s_add_u32 s11, s11, 4096
    buffer_load_dwordx4 v[104:107], v0, s[56:59], s11 offen offset:0 sc1
    buffer_load_dwordx4 v[136:139], v0, s[56:59], s11 offen offset:1024 sc1
    buffer_load_dwordx4 v[108:111], v0, s[56:59], s11 offen offset:2048 sc1
    buffer_load_dwordx4 v[140:143], v0, s[56:59], s11 offen offset:3072 sc1
    s_add_u32 s11, s11, 4096
    buffer_load_dwordx4 v[112:115], v0, s[56:59], s11 offen offset:0 sc1
    buffer_load_dwordx4 v[144:147], v0, s[56:59], s11 offen offset:1024 sc1
    buffer_load_dwordx4 v[116:119], v0, s[56:59], s11 offen offset:2048 sc1
    buffer_load_dwordx4 v[148:151], v0, s[56:59], s11 offen offset:3072 sc1
    s_add_u32 s11, s11, 4096
    buffer_load_dwordx4 v[120:123], v0, s[56:59], s11 offen offset:0 sc1
    buffer_load_dwordx4 v[152:155], v0, s[56:59], s11 offen offset:1024 sc1
    buffer_load_dwordx4 v[124:127], v0, s[56:59], s11 offen offset:2048 sc1
    buffer_load_dwordx4 v[156:159], v0, s[56:59], s11 offen offset:3072 sc1
    s_sub_u32 s13, s13, 1
    s_cbranch_scc1 L_pollqx
    s_waitcnt vmcnt(0)
    v_subrev_u32 v99, s62, v99
    v_subrev_u32 v103, s62, v103
    v_subrev_u32 v107, s62, v107
    v_subrev_u32 v111, s62, v111
    v_subrev_u32 v115, s62, v115
    v_subrev_u32 v119, s62, v119
    v_subrev_u32 v123, s62, v123
    v_subrev_u32 v127, s62, v127
    v_subrev_u32 v131, s62, v131
    v_subrev_u32 v135, s62, v135
    v_subrev_u32 v139, s62, v139
    v_subrev_u32 v143, s62, v143
    v_subrev_u32 v147, s62, v147
    v_subrev_u32 v151, s62, v151
    v_subrev_u32 v155, s62, v155
    v_subrev_u32 v159, s62, v159
    v_or3_b32 v9, v99, v103, v107
    v_or3_b32 v10, v111, v115, v119
    v_or3_b32 v10, v10, v123, v127
    v_or3_b32 v9, v9, v131, v135
    v_or3_b32 v10, v10, v139, v143
    v_or3_b32 v9, v9, v147, v151
    v_or3_b32 v10, v10, v155, v159
    v_or_b32 v9, v9, v10
    v_cmp_lt_u32 vcc, 15, v9
    s_cbranch_vccnz L_pollq
L_pollqx:
    v_xor_b32 v32, s55, v99
    v_xor_b32 v33, s55, v103
    v_xor_b32 v34, s55, v107
    v_xor_b32 v35, s55, v111
    v_xor_b32 v36, s55, v115
    v_xor_b32 v37, s55, v119
    v_xor_b32 v38, s55, v123
    v_xor_b32 v39, s55, v127
    v_pk_add_f32 v[96:97], v[96:97], v[100:101]
    v_pk_add_f32 v[98:99], v[98:99], v[102:103]
    v_pk_add_f32 v[104:105], v[104:105], v[108:109]
    v_pk_add_f32 v[106:107], v[106:107], v[110:111]
    v_pk_add_f32 v[112:113], v[112:113], v[116:117]
    v_pk_add_f32 v[114:115], v[114:115], v[118:119]
    v_pk_add_f32 v[120:121], v[120:121], v[124:125]
    v_pk_add_f32 v[122:123], v[122:123], v[126:127]
    v_pk_add_f32 v[96:97], v[96:97], v[104:105]
    v_pk_add_f32 v[98:99], v[98:99], v[106:107]
    v_pk_add_f32 v[112:113], v[112:113], v[120:121]
    v_pk_add_f32 v[114:115], v[114:115], v[122:123]
    v_pk_add_f32 v[96:97], v[96:97], v[112:113]
    v_pk_add_f32 v[98:99], v[98:99], v[114:115]
    v_cvt_pk_bf16_f32 v10, v96, v97
    v_cvt_pk_bf16_f32 v11, v98, v98
    v_mov_b32 v9, 0
    ds_write_b16 v7, v10 offset:15360
    ds_write_b16_d16_hi v7, v10 offset:15488
    ds_write_b16 v7, v11 offset:15616
    s_waitcnt lgkmcnt(0)
    ds_write_b32 v9, v9 offset:15808
    v_or3_b32 v9, v32, v33, v34
    v_or3_b32 v10, v35, v36, v37
    v_or3_b32 v9, v9, v38, v39
    v_or_b32 v9, v9, v10
    s_nop 0
    v_readfirstlane_b32 s10, v9
    s_cmp_eq_u32 s10, 0
    s_cbranch_scc1 L_q2
    buffer_store_dwordx4 v[24:27], v0, s[56:59], s53 offen sc1
    buffer_store_dwordx4 v[28:31], v0, s[56:59], s53 offen offset:1024 sc1
    s_waitcnt vmcnt(0)
L_q2:
    v_pk_add_f32 v[128:129], v[128:129], v[132:133]
    v_pk_add_f32 v[136:137], v[136:137], v[140:141]
    v_pk_add_f32 v[144:145], v[144:145], v[148:149]
    v_pk_add_f32 v[152:153], v[152:153], v[156:157]
    v_pk_add_f32 v[128:129], v[128:129], v[136:137]
    v_pk_add_f32 v[144:145], v[144:145], v[152:153]
    v_pk_add_f32 v[128:129], v[128:129], v[144:145]
    v_cvt_pk_bf16_f32 v10, v128, v129
    v_mov_b32 v16, 0xc0135761
    s_mov_b32 s11, 0xbdd2d3e8
    v_and_b32 v11, 0xffff0000, v10
    v_lshlrev_b32 v10, 16, v10
    v_mul_f32 v12, v10, v10
    v_fma_f32 v12, v12, s11, v16
    v_mul_f32 v12, v12, v10
    v_exp_f32 v12, v12
    s_nop 0
    v_add_f32 v12, 1.0, v12
    v_rcp_f32 v12, v12
    s_nop 0
    v_mul_f32 v10, v10, v12
    v_cvt_pk_bf16_f32 v10, v10, v10
    v_lshlrev_b32 v10, 16, v10
    v_mul_f32 v10, v10, v11
    s_nop 1
    v_mov_b32_dpp v11, v10 row_ror:8 row_mask:0xf bank_mask:0xf
    v_cvt_pk_bf16_f32 v10, v10, v11
    s_mov_b32 s11, 0x05040100
    s_mov_b32 s12, 0x07060302
    v_readlane_b32 s16, v10, 0
    v_readlane_b32 s17, v10, 32
    v_readlane_b32 s18, v10, 16
    v_readlane_b32 s19, v10, 48
    v_readlane_b32 s20, v10, 1
    v_readlane_b32 s21, v10, 33
    v_readlane_b32 s22, v10, 17
    v_readlane_b32 s23, v10, 49
    v_readlane_b32 s24, v10, 2
    v_readlane_b32 s25, v10, 34
    v_readlane_b32 s26, v10, 18
    v_readlane_b32 s27, v10, 50
    v_readlane_b32 s28, v10, 3
    v_readlane_b32 s29, v10, 35
    v_readlane_b32 s30, v10, 19
    v_readlane_b32 s31, v10, 51
    v_readlane_b32 s32, v10, 4
    v_readlane_b32 s33, v10, 36
    v_readlane_b32 s34, v10, 20
    v_readlane_b32 s35, v10, 52
    v_readlane_b32 s36, v10, 5
    v_readlane_b32 s37, v10, 37
    v_readlane_b32 s38, v10, 21
    v_readlane_b32 s39, v10, 53
    v_mov_b32 v16, 0
    v_mov_b32 v17, 0
    v_mov_b32 v18, 0
    v_mov_b32 v19, 0
    s_waitcnt vmcnt(0)
    v_perm_b32 v40, v43, v42, s11
    v_perm_b32 v41, v43, v42, s12
    v_perm_b32 v42, v45, v44, s11
    v_perm_b32 v43, v45, v44, s12
    v_perm_b32 v44, v47, v46, s11
    v_perm_b32 v45, v47, v46, s12
    v_perm_b32 v46, v49, v48, s11
    v_perm_b32 v47, v49, v48, s12
    v_perm_b32 v48, v51, v50, s11
    v_perm_b32 v49, v51, v50, s12
    v_perm_b32 v50, v53, v52, s11
    v_perm_b32 v51, v53, v52, s12
    v_perm_b32 v52, v55, v54, s11
    v_perm_b32 v53, v55, v54, s12
    v_perm_b32 v54, v57, v56, s11
    v_perm_b32 v55, v57, v56, s12
    v_perm_b32 v56, v59, v58, s11
    v_perm_b32 v57, v59, v58, s12
    v_perm_b32 v58, v61, v60, s11
    v_perm_b32 v59, v61, v60, s12
    v_perm_b32 v60, v63, v62, s11
    v_perm_b32 v61, v63, v62, s12
    v_perm_b32 v62, v65, v64, s11
    v_perm_b32 v63, v65, v64, s12
    v_perm_b32 v64, v67, v66, s11
    v_perm_b32 v65, v67, v66, s12
    v_perm_b32 v66, v69, v68, s11
    v_perm_b32 v67, v69, v68, s12
    v_perm_b32 v68, v71, v70, s11
    v_perm_b32 v69, v71, v70, s12
    v_perm_b32 v70, v73, v72, s11
    v_perm_b32 v71, v73, v72, s12
    v_perm_b32 v72, v75, v74, s11
    v_perm_b32 v73, v75, v74, s12
    v_perm_b32 v74, v77, v76, s11
    v_perm_b32 v75, v77, v76, s12
    v_perm_b32 v76, v79, v78, s11
    v_perm_b32 v77, v79, v78, s12
    v_perm_b32 v78, v81, v80, s11
    v_perm_b32 v79, v81, v80, s12
    v_perm_b32 v80, v83, v82, s11
    v_perm_b32 v81, v83, v82, s12
    v_perm_b32 v82, v85, v84, s11
    v_perm_b32 v83, v85, v84, s12
    v_perm_b32 v84, v87, v86, s11
    v_perm_b32 v85, v87, v86, s12
    v_perm_b32 v86, v89, v88, s11
    v_perm_b32 v87, v89, v88, s12
    v_dot2c_f32_bf16 v16, s16, v40
    v_dot2c_f32_bf16 v17, s16, v41
    v_dot2c_f32_bf16 v18, s17, v42
    v_dot2c_f32_bf16 v19, s17, v43
    v_dot2c_f32_bf16 v16, s18, v44
    v_dot2c_f32_bf16 v17, s18, v45
    v_dot2c_f32_bf16 v18, s19, v46
    v_dot2c_f32_bf16 v19, s19, v47
    v_dot2c_f32_bf16 v16, s20, v48
    v_dot2c_f32_bf16 v17, s20, v49
    v_dot2c_f32_bf16 v18, s21, v50
    v_dot2c_f32_bf16 v19, s21, v51
    v_dot2c_f32_bf16 v16, s22, v52
    v_dot2c_f32_bf16 v17, s22, v53
    v_dot2c_f32_bf16 v18, s23, v54
    v_dot2c_f32_bf16 v19, s23, v55
    v_dot2c_f32_bf16 v16, s24, v56
    v_dot2c_f32_bf16 v17, s24, v57
    v_dot2c_f32_bf16 v18, s25, v58
    v_dot2c_f32_bf16 v19, s25, v59
    v_dot2c_f32_bf16 v16, s26, v60
    v_dot2c_f32_bf16 v17, s26, v61
    v_dot2c_f32_bf16 v18, s27, v62
    v_dot2c_f32_bf16 v19, s27, v63
    v_dot2c_f32_bf16 v16, s28, v64
    v_dot2c_f32_bf16 v17, s28, v65
    v_dot2c_f32_bf16 v18, s29, v66
    v_dot2c_f32_bf16 v19, s29, v67
    v_dot2c_f32_bf16 v16, s30, v68
    v_dot2c_f32_bf16 v17, s30, v69
    v_dot2c_f32_bf16 v18, s31, v70
    v_dot2c_f32_bf16 v19, s31, v71
    v_dot2c_f32_bf16 v16, s32, v72
    v_dot2c_f32_bf16 v17, s32, v73
    v_dot2c_f32_bf16 v18, s33, v74
    v_dot2c_f32_bf16 v19, s33, v75
    v_dot2c_f32_bf16 v16, s34, v76
    v_dot2c_f32_bf16 v17, s34, v77
    v_dot2c_f32_bf16 v18, s35, v78
    v_dot2c_f32_bf16 v19, s35, v79
    v_dot2c_f32_bf16 v16, s36, v80
    v_dot2c_f32_bf16 v17, s36, v81
    v_dot2c_f32_bf16 v18, s37, v82
    v_dot2c_f32_bf16 v19, s37, v83
    v_dot2c_f32_bf16 v16, s38, v84
    v_dot2c_f32_bf16 v17, s38, v85
    v_dot2c_f32_bf16 v18, s39, v86
    v_dot2c_f32_bf16 v19, s39, v87
    s_nop 2
    v_pk_add_f32 v[16:17], v[16:17], v[18:19]
    ds_write_b32 v3, v16 offset:24576
    ds_write_b32 v4, v17 offset:24576
    v_mov_b32 v9, 0
    s_mov_b32 s13, 4800000
L_pollm:
    ds_read_b128 v[24:27], v9 offset:15744
    ds_read_b128 v[28:31], v9 offset:15760
    ds_read_b128 v[32:35], v9 offset:15776
    ds_read_b128 v[36:39], v9 offset:15792
    s_sub_u32 s13, s13, 1
    s_cbranch_scc1 L_pollmx
    s_waitcnt lgkmcnt(0)
    v_max3_u32 v10, v25, v27, v29
    v_max3_u32 v11, v31, v33, v35
    v_max3_u32 v10, v10, v37, v39
    v_max_u32 v10, v10, v11
    v_cmp_eq_u32 vcc, -1, v10
    s_cbranch_vccz L_pollmx
    s_sleep 16
    s_branch L_pollm
L_pollmx:
    v_max3_f32 v10, v24, v26, v28
    v_max3_f32 v11, v30, v32, v34
    v_max3_f32 v10, v10, v36, v38
    v_max_f32 v10, v10, v11
    v_sub_f32 v24, v24, v10
    v_sub_f32 v26, v26, v10
    v_sub_f32 v28, v28, v10
    v_sub_f32 v30, v30, v10
    v_sub_f32 v32, v32, v10
    v_sub_f32 v34, v34, v10
    v_sub_f32 v36, v36, v10
    v_sub_f32 v38, v38, v10
    v_exp_f32 v24, v24
    v_exp_f32 v26, v26
    v_exp_f32 v28, v28
    v_exp_f32 v30, v30
    v_exp_f32 v32, v32
    v_exp_f32 v34, v34
    v_exp_f32 v36, v36
    v_exp_f32 v38, v38
    v_mul_f32 v11, v24, v25
    v_fmac_f32 v11, v26, v27
    v_fmac_f32 v11, v28, v29
    v_fmac_f32 v11, v30, v31
    v_fmac_f32 v11, v32, v33
    v_fmac_f32 v11, v34, v35
    v_fmac_f32 v11, v36, v37
    v_fmac_f32 v11, v38, v39
    v_mov_b32 v12, s62
    v_mov_b32 v13, s62
    s_lshl_b32 s11, s3, 7
    s_add_u32 s11, s11, 917504
    s_mov_b64 exec, 1
    s_cmp_eq_u32 s10, 0
    s_cbranch_scc0 L_sx1
    buffer_store_dwordx4 v[10:13], off, s[56:59], s11
    s_branch L_sx2
L_sx1:
    buffer_store_dwordx4 v[10:13], off, s[56:59], s11 sc1
L_sx2:
    s_mov_b64 exec, -1
    v_mov_b32 v9, 0
    s_mov_b32 s13, 4800000
L_wait1:
    ds_read_b32 v14, v9 offset:15812
    s_sub_u32 s13, s13, 1
    s_cbranch_scc1 L_wait1x
    s_waitcnt lgkmcnt(0)
    v_cmp_eq_u32 vcc, -1, v14
    s_cbranch_vccz L_wait1x
    s_sleep 16
    s_branch L_wait1
L_wait1x:
    s_lshl_b32 s11, s4, 10
    s_add_u32 s11, s11, 917504
    v_lshlrev_b32 v9, 3, v5
    s_mov_b32 s13, 600000
L_polls:
    buffer_load_dwordx4 v[12:15], v9, s[56:59], s11 offen sc1
    s_sub_u32 s13, s13, 1
    s_cbranch_scc1 L_pollsx
    s_waitcnt vmcnt(0)
    v_cmp_ne_u32 vcc, s62, v14
    s_cbranch_vccz L_pollsx
    s_sleep 8
    s_branch L_polls
L_pollsx:
    v_mov_b32 v14, v12
    s_nop 1
    v_max_f32_dpp v14, v14, v14 quad_perm:[1,0,3,2] row_mask:0xf bank_mask:0xf
    s_nop 1
    v_max_f32_dpp v14, v14, v14 quad_perm:[2,3,0,1] row_mask:0xf bank_mask:0xf
    s_nop 1
    v_max_f32_dpp v14, v14, v14 row_half_mirror row_mask:0xf bank_mask:0xf
    v_sub_f32 v12, v12, v14
    v_sub_f32 v10, v10, v14
    v_exp_f32 v12, v12
    v_exp_f32 v10, v10
    v_mul_f32 v13, v13, v12
    s_nop 1
    v_add_f32_dpp v13, v13, v13 quad_perm:[1,0,3,2] row_mask:0xf bank_mask:0xf
    s_nop 1
    v_add_f32_dpp v13, v13, v13 quad_perm:[2,3,0,1] row_mask:0xf bank_mask:0xf
    s_nop 1
    v_add_f32_dpp v13, v13, v13 row_half_mirror row_mask:0xf bank_mask:0xf
    v_rcp_f32 v13, v13
    s_nop 0
    v_mul_f32 v10, v10, v13
    v_mul_f32 v24, v24, v10
    v_mul_f32 v26, v26, v10
    v_mul_f32 v28, v28, v10
    v_mul_f32 v30, v30, v10
    v_mul_f32 v32, v32, v10
    v_mul_f32 v34, v34, v10
    v_mul_f32 v36, v36, v10
    v_mul_f32 v38, v38, v10
    v_mov_b32 v25, v24
    v_mov_b32 v27, v26
    v_mov_b32 v29, v28
    v_mov_b32 v31, v30
    v_mov_b32 v33, v32
    v_mov_b32 v35, v34
    v_mov_b32 v37, v36
    v_mov_b32 v39, v38
    ds_read_b128 v[16:19], v0 offset:32768
    v_mov_b32 v12, 0
    v_mov_b32 v13, 0
    v_mov_b32 v14, 0
    v_mov_b32 v20, 0
    v_mov_b32 v21, 0
    v_mov_b32 v22, 0
    s_add_u32 s11, s62, 16
    v_mov_b32 v15, s11
    s_mov_b32 s7, s52
    v_mov_b32 v2, v0
    s_cmp_eq_u32 s10, 0
    s_waitcnt lgkmcnt(0)
    v_mov_b32 v19, s62
    s_barrier
    s_barrier
    ds_read_b128 v[64:67], v0 offset:16384
    ds_read_b128 v[68:71], v0 offset:17408
    ds_read_b128 v[72:75], v0 offset:18432
    ds_read_b128 v[76:79], v0 offset:19456
    ds_read_b128 v[80:83], v0 offset:20480
    ds_read_b128 v[84:87], v0 offset:21504
    ds_read_b128 v[88:91], v0 offset:22528
    ds_read_b128 v[92:95], v0 offset:23552
    s_waitcnt lgkmcnt(7)
    v_pk_fma_f32 v[12:13], v[64:65], v[24:25], v[12:13]
    v_fmac_f32 v14, v66, v24
    s_waitcnt lgkmcnt(6)
    v_pk_fma_f32 v[20:21], v[68:69], v[26:27], v[20:21]
    v_fmac_f32 v22, v70, v26
    s_waitcnt lgkmcnt(5)
    v_pk_fma_f32 v[12:13], v[72:73], v[28:29], v[12:13]
    v_fmac_f32 v14, v74, v28
    s_waitcnt lgkmcnt(4)
    v_pk_fma_f32 v[20:21], v[76:77], v[30:31], v[20:21]
    v_fmac_f32 v22, v78, v30
    s_waitcnt lgkmcnt(3)
    v_pk_fma_f32 v[12:13], v[80:81], v[32:33], v[12:13]
    v_fmac_f32 v14, v82, v32
    s_waitcnt lgkmcnt(2)
    v_pk_fma_f32 v[20:21], v[84:85], v[34:35], v[20:21]
    v_fmac_f32 v22, v86, v34
    s_waitcnt lgkmcnt(1)
    v_pk_fma_f32 v[12:13], v[88:89], v[36:37], v[12:13]
    v_fmac_f32 v14, v90, v36
    s_waitcnt lgkmcnt(0)
    v_pk_fma_f32 v[20:21], v[92:93], v[38:39], v[20:21]
    v_fmac_f32 v22, v94, v38
    v_pk_add_f32 v[12:13], v[12:13], v[20:21]
    v_add_f32 v14, v14, v22
    s_cbranch_scc0 L_c2
    buffer_store_dwordx4 v[12:15], v2, s[56:59], s7 offen
    s_branch L_c2x
L_c2:
    buffer_store_dwordx4 v[12:15], v2, s[56:59], s7 offen sc1
L_c2x:
    s_mov_b32 exec_hi, 0
    s_waitcnt lgkmcnt(0)
    s_barrier
    ds_read_b128 v[64:67], v0 offset:24576
    ds_read_b128 v[68:71], v0 offset:25600
    ds_read_b128 v[72:75], v0 offset:26624
    ds_read_b128 v[76:79], v0 offset:27648
    ds_read_b128 v[80:83], v0 offset:28672
    ds_read_b128 v[84:87], v0 offset:29696
    ds_read_b128 v[88:91], v0 offset:30720
    ds_read_b128 v[92:95], v0 offset:31744
    s_waitcnt lgkmcnt(6)
    v_pk_add_f32 v[64:65], v[64:65], v[68:69]
    v_add_f32 v66, v66, v70
    s_waitcnt lgkmcnt(4)
    v_pk_add_f32 v[72:73], v[72:73], v[76:77]
    v_add_f32 v74, v74, v78
    v_pk_add_f32 v[16:17], v[16:17], v[64:65]
    v_add_f32 v18, v18, v66
    s_waitcnt lgkmcnt(2)
    v_pk_add_f32 v[80:81], v[80:81], v[84:85]
    v_add_f32 v82, v82, v86
    v_pk_add_f32 v[16:17], v[16:17], v[72:73]
    v_add_f32 v18, v18, v74
    s_waitcnt lgkmcnt(0)
    v_pk_add_f32 v[88:89], v[88:89], v[92:93]
    v_add_f32 v90, v90, v94
    v_pk_add_f32 v[16:17], v[16:17], v[80:81]
    v_add_f32 v18, v18, v82
    v_pk_add_f32 v[16:17], v[16:17], v[88:89]
    v_add_f32 v18, v18, v90
    buffer_store_dwordx4 v[16:19], v0, s[56:59], s8 offen sc1
L_fin:
L_end:
    s_endpgm
.section .rodata,"a"
.p2align 6
.amdhsa_kernel parallel_sum__gqa_block_cached__glu_gated_geglu__decode_kernel
  .amdhsa_next_free_vgpr 160
  .amdhsa_next_free_sgpr 80
  .amdhsa_accum_offset 160
  .amdhsa_group_segment_fixed_size 0
  .amdhsa_kernarg_size 96
  .amdhsa_user_sgpr_count 2
  .amdhsa_user_sgpr_kernarg_segment_ptr 1
  .amdhsa_system_sgpr_workgroup_id_x 1
  .amdhsa_float_denorm_mode_32 3
.end_amdhsa_kernel
```
